```python
import torch

def _softmax(x, axis=-1):
    return torch.softmax(x, dim=axis)
def _gelu(x):
    return torch.nn.functional.gelu(x, approximate="tanh")
def _silu(x):
    return torch.nn.functional.silu(x)
def _sigmoid(x):
    return torch.sigmoid(x)
def _layernorm(x, axis=-1, eps=1e-5):
    m = x.mean(dim=axis, keepdim=True)
    v = x.var(dim=axis, keepdim=True, unbiased=False)
    return (x - m) / torch.sqrt(v + eps)
def _scatter_add(tgt, idx, src, axis=0):
    return tgt.clone().index_add_(axis, idx, src)
def _segment_sum(src, seg, n):
    out = torch.zeros((n,) + src.shape[1:], dtype=src.dtype)
    return out.index_add_(0, seg, src)
def _pad(x, pw):
    flat = tuple(v for pair in reversed(pw) for v in pair)
    return torch.nn.functional.pad(x, flat)

kernel_name = 'recurrent_scan__sliding_block_cached__glu_gated_geglu__decode'

def setup_inputs():

    _w = (lambda a: (lambda t: t.to(torch.bfloat16) if t.is_floating_point() else t)(torch.as_tensor(a)))
    def _A_setup():
        B, Sq, D = 1, 1, 512
        Hq, Hkv, Sk, Dh = 32, 8, 65536, 128
        assert Hq % Hkv == 0, (Hq, Hkv)
        return {
            "x": _w((lambda *s: torch.randn(*s, dtype=torch.bfloat16) * 0.4)(B, Sq, D)),
            "k_cache": _w((lambda *s: torch.randn(*s, dtype=torch.bfloat16) * 1.6)(B, Hkv, Sk, Dh)),
            "v_cache": _w((lambda *s: torch.randn(*s, dtype=torch.bfloat16) * 1.6)(B, Hkv, Sk, Dh)),
            "wq": _w((lambda *s: torch.randn(*s, dtype=torch.bfloat16) * 1.6)(D, Hq * Dh) * (D ** -0.5)),
            "wo": _w((lambda *s: torch.randn(*s, dtype=torch.bfloat16) * 1.6)(Hq * Dh, D) * ((Hq * Dh) ** -0.5)),
        }
    _A_in = _A_setup()

    def _B_setup():
        B, S, Dm, Df = 1, 1, 512, 1792
        return {
            "x": _w((lambda *s: torch.randn(*s, dtype=torch.bfloat16) * 0.4)(B, S, Dm)),
            "w_gate": _w((lambda *s: torch.randn(*s, dtype=torch.bfloat16) * 1.6)(Dm, Df) * (Dm ** -0.5)),
            "w_up": _w((lambda *s: torch.randn(*s, dtype=torch.bfloat16) * 1.6)(Dm, Df) * (Dm ** -0.5)),
            "w_down": _w((lambda *s: torch.randn(*s, dtype=torch.bfloat16) * 1.6)(Df, Dm) * (Df ** -0.5)),
        }
    _B_in = _B_setup()

    return {
        "A_x": _A_in["x"],
        "A_k_cache": _A_in["k_cache"],
        "A_v_cache": _A_in["v_cache"],
        "A_wq": _A_in["wq"],
        "A_wo": _A_in["wo"],
        "B_x": _B_in["x"],
        "B_w_gate": _B_in["w_gate"],
        "B_w_up": _B_in["w_up"],
        "B_w_down": _B_in["w_down"],
    }

def reference(A_x, A_k_cache, A_v_cache, A_wq, A_wo, B_x, B_w_gate, B_w_up, B_w_down):
    def _A_ref(x, k_cache, v_cache, wq, wo):
        B, Sq, D = x.shape
        Hq, Dh = 32, 128
        Hkv, Sk = k_cache.shape[1], k_cache.shape[2]
        W = min(4096, max(256, Sk // 4))
        rep = Hq // Hkv
        q = (lambda x, *d: x.permute(*d))((x @ wq).reshape(B, Sq, Hq, Dh), 0, 2, 1, 3)
        k = (lambda x, n, axis: torch.repeat_interleave(x, n, dim=axis))(k_cache[:, :, Sk - W:, :], rep, axis=1)
        v = (lambda x, n, axis: torch.repeat_interleave(x, n, dim=axis))(v_cache[:, :, Sk - W:, :], rep, axis=1)
        scores = torch.einsum("bhqd,bhkd->bhqk", q, k) * (Dh ** -0.5)
        p = _softmax(scores, axis=-1)
        o = torch.einsum("bhqk,bhkd->bhqd", p, v)
        return (lambda x, *d: x.permute(*d))(o, 0, 2, 1, 3).reshape(B, Sq, Hq * Dh) @ wo

    def _B_ref(x, w_gate, w_up, w_down):
        g = torch.einsum("bsd,df->bsf", x, w_gate)
        u = torch.einsum("bsd,df->bsf", x, w_up)
        h = _gelu(g) * u
        return torch.einsum("bsf,fd->bsd", h, w_down)

    x = A_x
    xn = _layernorm(x, axis=-1)
    s = _A_ref(xn, A_k_cache, A_v_cache, A_wq, A_wo)
    g = _silu(_B_ref(xn, B_w_gate, B_w_up, B_w_down))
    return x + s * g
```

```asm
; @launch grid=(256,1,1) block=(640,1,1) lds=128256
.amdgcn_target "amdgcn-amd-amdhsa--gfx950"
.text
.globl recurrent_scan__sliding_block_cached__glu_gated_geglu__decode_kernel
.p2align 8
.p2align 12
.type recurrent_scan__sliding_block_cached__glu_gated_geglu__decode_kernel,@function
recurrent_scan__sliding_block_cached__glu_gated_geglu__decode_kernel:
  s_cmp_ge_u32 s2, 256
  s_cbranch_scc1 L_exit
  s_load_dwordx16 s[4:19], s[0:1], 0
  s_load_dwordx8 s[20:27], s[0:1], 64
  v_lshrrev_b32 v1, 6, v0
  v_and_b32 v0, 63, v0
  v_readfirstlane_b32 s3, v1
  s_cmp_ge_u32 s3, 6
  s_cbranch_scc1 L_att
  s_cmp_ge_u32 s3, 2
  s_cbranch_scc1 L_g
  s_cmp_eq_u32 s3, 0
  s_cbranch_scc1 L_loader
  v_lshlrev_b32 v3, 4, v0
  s_waitcnt lgkmcnt(0)
  global_load_dwordx4 v[8:11], v3, s[4:5]
  s_branch L_q
L_loader:
  s_setprio 3
  s_getpc_b64 s[66:67]
L_pc:
  v_lshlrev_b32 v30, 7, v0
  s_sub_u32 s66, s66, L_pc-recurrent_scan__sliding_block_cached__glu_gated_geglu__decode_kernel
  s_subb_u32 s67, s67, 0
  v_add_u32 v31, 0x2000, v30
  global_load_dword v32, v30, s[66:67] offset:128
  v_cmp_gt_u32 vcc, L_code_end-recurrent_scan__sliding_block_cached__glu_gated_geglu__decode_kernel-128, v31
  s_mov_b64 exec, vcc
  global_load_dword v33, v31, s[66:67] offset:128
  s_mov_b64 exec, -1
  s_and_b32 s28, s2, 7
  s_lshr_b32 s29, s2, 3
  v_and_b32 v1, 15, v0
  v_lshrrev_b32 v2, 4, v0
  v_mov_b32 v7, 126208
  s_mov_b32 s59, s2
  s_mul_i32 s63, s59, 4682
  s_lshr_b32 s63, s63, 16
  s_mul_i32 s64, s63, 14
  s_sub_u32 s64, s59, s64
  s_lshr_b32 s70, s29, 1
  s_lshl_b32 s71, s28, 4
  s_add_u32 s70, s70, s71
  s_and_b32 s71, s29, 1
  v_cmp_eq_u32 vcc, 1, v2
  v_mov_b32 v28, 0
  v_lshl_add_u32 v25, v0, 2, v7
  v_cndmask_b32 v29, 0, -1, vcc
  ds_write2st64_b32 v25, v28, v29 offset0:0 offset1:1
  v_mov_b32 v24, 1
  v_lshrrev_b32 v4, 3, v0
  v_and_b32 v5, 7, v0
  v_and_b32 v6, 1, v2
  v_lshlrev_b32 v6, 1, v6
  v_xor_b32 v5, v5, v6
  v_lshlrev_b32 v5, 4, v5
  v_lshl_or_b32 v26, v4, 13, v5
  v_xor_b32 v27, 64, v26
  s_lshl_b32 s60, s28, 10
  s_and_b32 s61, s29, 7
  s_lshl_b32 s61, s61, 7
  s_add_u32 s60, s60, s61
  s_lshr_b32 s61, s29, 3
  s_lshl_b32 s61, s61, 20
  s_add_u32 s60, s60, s61
  s_mov_b32 s68, 0x10000
  s_mov_b32 s34, 4194304
  s_mov_b32 s35, 0x20000
  s_mov_b32 m0, 0
  s_lshl_b32 s61, s28, 16
  s_lshl_b32 s62, s29, 7
  s_add_u32 s61, s61, s62
  s_add_u32 s61, s61, 61440
  s_lshl_b32 s61, s61, 8
  v_xor_b32 v4, v1, v2
  v_lshlrev_b32 v4, 4, v4
  v_lshl_add_u32 v8, v2, 8, v4
  v_xor_b32 v9, 64, v8
  v_xor_b32 v10, 0x80, v8
  v_xor_b32 v11, 0xc0, v8
  s_movk_i32 s69, 1024
  s_waitcnt lgkmcnt(0)
  s_mov_b32 s32, s10
  s_and_b32 s33, s11, 0xffff
  buffer_load_dwordx4 v26, s[32:35], s60 offen nt lds
  s_add_u32 m0, m0, s69
  s_add_u32 s60, s60, s68
  buffer_load_dwordx4 v27, s[32:35], s60 offen nt lds
  s_add_u32 m0, m0, s69
  s_add_u32 s60, s60, s68
  buffer_load_dwordx4 v26, s[32:35], s60 offen nt lds
  s_add_u32 m0, m0, s69
  s_add_u32 s60, s60, s68
  buffer_load_dwordx4 v27, s[32:35], s60 offen nt lds
  s_add_u32 m0, m0, s69
  s_add_u32 s60, s60, s68
  buffer_load_dwordx4 v26, s[32:35], s60 offen nt lds
  s_add_u32 m0, m0, s69
  s_add_u32 s60, s60, s68
  buffer_load_dwordx4 v27, s[32:35], s60 offen nt lds
  s_add_u32 m0, m0, s69
  s_add_u32 s60, s60, s68
  buffer_load_dwordx4 v26, s[32:35], s60 offen nt lds
  s_add_u32 m0, m0, s69
  s_add_u32 s60, s60, s68
  buffer_load_dwordx4 v27, s[32:35], s60 offen nt lds
  s_add_u32 m0, m0, s69
  s_add_u32 s60, s60, s68
  buffer_load_dwordx4 v26, s[32:35], s60 offen nt lds
  s_add_u32 m0, m0, s69
  s_add_u32 s60, s60, s68
  buffer_load_dwordx4 v27, s[32:35], s60 offen nt lds
  s_add_u32 m0, m0, s69
  s_add_u32 s60, s60, s68
  buffer_load_dwordx4 v26, s[32:35], s60 offen nt lds
  s_add_u32 m0, m0, s69
  s_add_u32 s60, s60, s68
  buffer_load_dwordx4 v27, s[32:35], s60 offen nt lds
  s_add_u32 m0, m0, s69
  s_add_u32 s60, s60, s68
  buffer_load_dwordx4 v26, s[32:35], s60 offen nt lds
  s_add_u32 m0, m0, s69
  s_add_u32 s60, s60, s68
  buffer_load_dwordx4 v27, s[32:35], s60 offen nt lds
  s_add_u32 m0, m0, s69
  s_add_u32 s60, s60, s68
  buffer_load_dwordx4 v26, s[32:35], s60 offen nt lds
  s_add_u32 m0, m0, s69
  s_add_u32 s60, s60, s68
  buffer_load_dwordx4 v27, s[32:35], s60 offen nt lds
  s_mov_b32 s40, s16
  s_and_b32 s41, s17, 0xffff
  s_cmp_lt_u32 s59, 224
  s_cselect_b32 s42, 1835008, 0
  s_mov_b32 s43, 0x20000
  s_mov_b32 s44, s18
  s_and_b32 s45, s19, 0xffff
  s_mov_b32 s46, s42
  s_mov_b32 s47, 0x20000
  s_mul_i32 s65, s63, 114688
  s_lshl_b32 s66, s64, 8
  s_add_u32 s65, s65, s66
  s_mov_b32 s62, s65
  s_movk_i32 s67, 14336
  v_lshlrev_b32 v4, 1, v2
  v_xor_b32 v4, v1, v4
  v_lshlrev_b32 v4, 4, v4
  v_mul_u32_u24 v5, 3584, v2
  v_add_u32 v14, v4, v5
  v_xor_b32 v4, 0x80, v4
  v_add_u32 v15, v4, v5
  s_mov_b32 m0, 81920
  s_nop 0
  buffer_load_dwordx4 v14, s[40:43], s62 offen nt lds
  s_add_u32 m0, m0, s69
  s_add_u32 s62, s62, s67
  buffer_load_dwordx4 v14, s[40:43], s62 offen nt lds
  s_add_u32 m0, m0, s69
  s_add_u32 s62, s62, s67
  buffer_load_dwordx4 v15, s[40:43], s62 offen nt lds
  s_add_u32 m0, m0, s69
  s_add_u32 s62, s62, s67
  buffer_load_dwordx4 v15, s[40:43], s62 offen nt lds
  s_add_u32 m0, m0, s69
  s_add_u32 s62, s62, s67
  buffer_load_dwordx4 v14, s[40:43], s62 offen nt lds
  s_add_u32 m0, m0, s69
  s_add_u32 s62, s62, s67
  buffer_load_dwordx4 v14, s[40:43], s62 offen nt lds
  s_add_u32 m0, m0, s69
  s_add_u32 s62, s62, s67
  buffer_load_dwordx4 v15, s[40:43], s62 offen nt lds
  s_add_u32 m0, m0, s69
  s_add_u32 s62, s62, s67
  buffer_load_dwordx4 v15, s[40:43], s62 offen nt lds
  s_add_u32 m0, m0, s69
  s_mov_b32 s62, s65
  s_barrier
  buffer_load_dwordx4 v14, s[44:47], s62 offen nt lds
  s_add_u32 m0, m0, s69
  s_add_u32 s62, s62, s67
  buffer_load_dwordx4 v14, s[44:47], s62 offen nt lds
  s_add_u32 m0, m0, s69
  s_add_u32 s62, s62, s67
  buffer_load_dwordx4 v15, s[44:47], s62 offen nt lds
  s_add_u32 m0, m0, s69
  s_add_u32 s62, s62, s67
  buffer_load_dwordx4 v15, s[44:47], s62 offen nt lds
  s_add_u32 m0, m0, s69
  s_add_u32 s62, s62, s67
  buffer_load_dwordx4 v14, s[44:47], s62 offen nt lds
  s_add_u32 m0, m0, s69
  s_add_u32 s62, s62, s67
  buffer_load_dwordx4 v14, s[44:47], s62 offen nt lds
  s_add_u32 m0, m0, s69
  s_add_u32 s62, s62, s67
  buffer_load_dwordx4 v15, s[44:47], s62 offen nt lds
  s_add_u32 m0, m0, s69
  s_add_u32 s62, s62, s67
  buffer_load_dwordx4 v15, s[44:47], s62 offen nt lds
  s_mov_b32 s36, s6
  s_and_b32 s37, s7, 0xffff
  s_mov_b32 s38, 134217728
  s_mov_b32 s39, 0x20000
  s_mov_b32 s62, s61
  s_mov_b32 m0, 16384
  s_mov_b32 s65, s29
  s_and_b32 s65, s65, 7
  s_lshl_b32 s65, s65, 12
  s_add_u32 s62, s61, s65
L_ld_k:
  s_waitcnt vmcnt(23)
  buffer_load_dwordx4 v8, s[36:39], s62 offen offset:0 nt lds
  ds_add_u32 v25, v24
  s_waitcnt vmcnt(23)
  buffer_load_dwordx4 v9, s[36:39], s62 offen offset:1024 nt lds
  ds_add_u32 v25, v24
  s_waitcnt vmcnt(23)
  buffer_load_dwordx4 v10, s[36:39], s62 offen offset:2048 nt lds
  ds_add_u32 v25, v24
  s_waitcnt vmcnt(23)
  buffer_load_dwordx4 v11, s[36:39], s62 offen offset:3072 nt lds
  ds_add_u32 v25, v24
  s_add_u32 s65, s65, 4096
  s_and_b32 s65, s65, 0x7fff
  s_add_u32 s62, s61, s65
  s_add_u32 m0, m0, 4096
  s_cmp_lt_u32 m0, 49152
  s_cbranch_scc1 L_ld_k
  s_mov_b32 s48, s8
  s_and_b32 s49, s9, 0xffff
  s_mov_b32 s50, 134217728
  s_mov_b32 s51, 0x20000
  v_lshlrev_b32 v4, 1, v2
  v_xor_b32 v4, v1, v4
  v_lshlrev_b32 v4, 4, v4
  v_lshl_add_u32 v12, v2, 8, v4
  v_xor_b32 v13, 0x80, v12
  s_mov_b32 m0, 49152
L_ld_v:
  s_waitcnt vmcnt(23)
  buffer_load_dwordx4 v12, s[48:51], s62 offen offset:0 nt lds
  ds_add_u32 v25, v24
  s_waitcnt vmcnt(23)
  buffer_load_dwordx4 v13, s[48:51], s62 offen offset:1024 nt lds
  ds_add_u32 v25, v24
  s_waitcnt vmcnt(23)
  buffer_load_dwordx4 v12, s[48:51], s62 offen offset:2048 nt lds
  ds_add_u32 v25, v24
  s_waitcnt vmcnt(23)
  buffer_load_dwordx4 v13, s[48:51], s62 offen offset:3072 nt lds
  ds_add_u32 v25, v24
  s_add_u32 s65, s65, 4096
  s_and_b32 s65, s65, 0x7fff
  s_add_u32 s62, s61, s65
  s_add_u32 m0, m0, 4096
  s_cmp_lt_u32 m0, 81920
  s_cbranch_scc1 L_ld_v
  s_mov_b32 s52, s20
  s_and_b32 s53, s21, 0xffff
  s_mov_b32 s54, 1835008
  s_mov_b32 s55, 0x20000
  v_lshrrev_b32 v5, 5, v0
  v_and_b32 v4, 31, v0
  v_lshlrev_b32 v6, 1, v5
  v_xor_b32 v4, v4, v6
  v_lshlrev_b32 v4, 4, v4
  v_lshl_add_u32 v16, v5, 10, v4
  v_xor_b32 v17, 0x40, v16
  v_xor_b32 v18, 0x80, v16
  v_xor_b32 v19, 0xc0, v16
  s_movk_i32 s68, 2048
  s_mul_i32 s62, s70, 14336
  s_lshl_b32 s66, s71, 9
  s_add_u32 s62, s62, s66
  s_mov_b32 m0, 114688
  s_waitcnt vmcnt(23)
  buffer_load_dwordx4 v16, s[52:55], s62 offen nt lds
  ds_add_u32 v25, v24
  s_add_u32 m0, m0, s69
  s_add_u32 s62, s62, s68
  s_waitcnt vmcnt(23)
  buffer_load_dwordx4 v17, s[52:55], s62 offen nt lds
  ds_add_u32 v25, v24
  s_add_u32 m0, m0, s69
  s_add_u32 s62, s62, s68
  s_waitcnt vmcnt(23)
  buffer_load_dwordx4 v18, s[52:55], s62 offen nt lds
  ds_add_u32 v25, v24
  s_add_u32 m0, m0, s69
  s_add_u32 s62, s62, s68
  s_waitcnt vmcnt(23)
  buffer_load_dwordx4 v19, s[52:55], s62 offen nt lds
  ds_add_u32 v25, v24
  s_add_u32 m0, m0, s69
  s_add_u32 s62, s62, s68
  s_waitcnt vmcnt(23)
  buffer_load_dwordx4 v16, s[52:55], s62 offen nt lds
  ds_add_u32 v25, v24
  s_add_u32 m0, m0, s69
  s_add_u32 s62, s62, s68
  s_waitcnt vmcnt(23)
  buffer_load_dwordx4 v17, s[52:55], s62 offen nt lds
  ds_add_u32 v25, v24
  s_add_u32 m0, m0, s69
  s_add_u32 s62, s62, s68
  s_waitcnt vmcnt(23)
  buffer_load_dwordx4 v18, s[52:55], s62 offen nt lds
  ds_add_u32 v25, v24
  s_mov_b32 s56, s12
  s_and_b32 s57, s13, 0xffff
  s_mov_b32 s58, 4194304
  s_mov_b32 s59, 0x20000
  v_lshrrev_b32 v5, 5, v0
  v_and_b32 v4, 31, v0
  v_lshlrev_b32 v6, 1, v5
  v_xor_b32 v4, v4, v6
  v_lshlrev_b32 v4, 4, v4
  v_lshl_add_u32 v20, v5, 10, v4
  v_xor_b32 v21, 0x40, v20
  v_xor_b32 v22, 0x80, v20
  v_xor_b32 v23, 0xc0, v20
  s_movk_i32 s68, 2048
  s_lshl_b32 s62, s70, 15
  s_lshl_b32 s66, s71, 9
  s_add_u32 s62, s62, s66
  s_mov_b32 m0, 98304
  s_lshr_b32 s65, s29, 1
  s_and_b32 s65, s65, 7
  s_add_u32 s66, s65, 3
  s_and_b32 s66, s66, 3
  s_lshl_b32 s66, s66, 6
  v_xor_b32 v23, s66, v20
  s_add_u32 s66, s65, 2
  s_and_b32 s66, s66, 3
  s_lshl_b32 s66, s66, 6
  v_xor_b32 v22, s66, v20
  s_add_u32 s66, s65, 1
  s_and_b32 s66, s66, 3
  s_lshl_b32 s66, s66, 6
  v_xor_b32 v21, s66, v20
  s_add_u32 s66, s65, 0
  s_and_b32 s66, s66, 3
  s_lshl_b32 s66, s66, 6
  v_xor_b32 v20, s66, v20
  s_mov_b32 s67, s62
  s_lshl_b32 s65, s65, 11
  s_add_u32 m0, s65, 98304
  s_lshl_b32 s66, s65, 1
  s_add_u32 s62, s67, s66
  s_mov_b32 s64, 0
L_ld_o:
  s_waitcnt vmcnt(23)
  buffer_load_dwordx4 v20, s[56:59], s62 offen nt lds
  ds_add_u32 v25, v24
  s_add_u32 m0, m0, s69
  s_add_u32 s62, s62, s68
  s_waitcnt vmcnt(23)
  buffer_load_dwordx4 v20, s[56:59], s62 offen nt lds
  ds_add_u32 v25, v24
  s_add_u32 s65, s65, s68
  s_and_b32 s65, s65, 0x3fff
  s_add_u32 m0, s65, 98304
  s_lshl_b32 s66, s65, 1
  s_add_u32 s62, s67, s66
  s_waitcnt vmcnt(23)
  buffer_load_dwordx4 v21, s[56:59], s62 offen nt lds
  ds_add_u32 v25, v24
  s_add_u32 m0, m0, s69
  s_add_u32 s62, s62, s68
  s_waitcnt vmcnt(23)
  buffer_load_dwordx4 v21, s[56:59], s62 offen nt lds
  ds_add_u32 v25, v24
  s_add_u32 s65, s65, s68
  s_and_b32 s65, s65, 0x3fff
  s_add_u32 m0, s65, 98304
  s_lshl_b32 s66, s65, 1
  s_add_u32 s62, s67, s66
  s_waitcnt vmcnt(23)
  buffer_load_dwordx4 v22, s[56:59], s62 offen nt lds
  ds_add_u32 v25, v24
  s_add_u32 m0, m0, s69
  s_add_u32 s62, s62, s68
  s_waitcnt vmcnt(23)
  buffer_load_dwordx4 v22, s[56:59], s62 offen nt lds
  ds_add_u32 v25, v24
  s_add_u32 s65, s65, s68
  s_and_b32 s65, s65, 0x3fff
  s_add_u32 m0, s65, 98304
  s_lshl_b32 s66, s65, 1
  s_add_u32 s62, s67, s66
  s_waitcnt vmcnt(23)
  buffer_load_dwordx4 v23, s[56:59], s62 offen nt lds
  ds_add_u32 v25, v24
  s_add_u32 m0, m0, s69
  s_add_u32 s62, s62, s68
  s_waitcnt vmcnt(23)
  buffer_load_dwordx4 v23, s[56:59], s62 offen nt lds
  ds_add_u32 v25, v24
  s_add_u32 s65, s65, s68
  s_and_b32 s65, s65, 0x3fff
  s_add_u32 m0, s65, 98304
  s_lshl_b32 s66, s65, 1
  s_add_u32 s62, s67, s66
  s_add_u32 s64, s64, 1
  s_cmp_lt_u32 s64, 2
  s_cbranch_scc1 L_ld_o
  s_waitcnt vmcnt(23)
  ds_add_u32 v25, v24
  s_waitcnt vmcnt(21)
  ds_add_u32 v25, v24
  s_waitcnt vmcnt(19)
  ds_add_u32 v25, v24
  s_waitcnt vmcnt(17)
  ds_add_u32 v25, v24
  s_waitcnt vmcnt(16)
  ds_add_u32 v25, v24
  s_waitcnt vmcnt(15)
  ds_add_u32 v25, v24
  s_waitcnt vmcnt(13)
  ds_add_u32 v25, v24
  s_waitcnt vmcnt(11)
  ds_add_u32 v25, v24
  s_waitcnt vmcnt(9)
  ds_add_u32 v25, v24
  s_waitcnt vmcnt(7)
  ds_add_u32 v25, v24
  s_waitcnt vmcnt(5)
  ds_add_u32 v25, v24
  s_waitcnt vmcnt(3)
  ds_add_u32 v25, v24
  s_waitcnt vmcnt(1)
  ds_add_u32 v25, v24
  s_waitcnt vmcnt(0)
  ds_add_u32 v25, v24
  s_waitcnt lgkmcnt(0)
  s_endpgm
L_exit:
  s_endpgm
L_q:
  s_and_b32 s28, s2, 7
  s_lshr_b32 s29, s2, 3
  v_and_b32 v1, 15, v0
  v_lshrrev_b32 v2, 4, v0
  v_mov_b32 v7, 126208
  s_mov_b32 s82, 400000
  s_mov_b32 s79, 0
  s_setprio 2
  v_lshlrev_b32 v3, 4, v0
  v_add_u32 v4, 122880, v3
  v_add_u32 v6, 126976, v3
  s_waitcnt lgkmcnt(0)
  s_load_dword s30, s[26:27], 0
  s_mov_b32 s32, s26
  s_and_b32 s33, s27, 0xffff
  s_mov_b32 s34, 1982464
  s_mov_b32 s35, 0x20000
  v_and_b32 v5, 31, v0
  v_lshlrev_b32 v5, 4, v5
  s_lshr_b32 s72, s29, 3
  s_lshl_b32 s73, s28, 11
  s_lshl_b32 s74, s72, 9
  s_add_u32 s73, s73, s74
  s_add_u32 s89, s73, 1900544
  s_add_u32 s73, s73, 4096
  v_lshlrev_b32 v60, 2, v0
  v_add_u32 v60, 126720, v60
  v_mov_b32 v61, 1
  s_mov_b32 s78, 0
  s_barrier
  s_waitcnt vmcnt(0)
  v_lshlrev_b32 v28, 16, v8
  v_and_b32 v29, 0xffff0000, v8
  v_lshlrev_b32 v30, 16, v9
  v_and_b32 v31, 0xffff0000, v9
  v_lshlrev_b32 v32, 16, v10
  v_and_b32 v33, 0xffff0000, v10
  v_lshlrev_b32 v34, 16, v11
  v_and_b32 v35, 0xffff0000, v11
  v_readfirstlane_b32 s60, v28
  ds_write_b128 v6, v[8:11]
  s_nop 0
  v_subrev_f32 v36, s60, v28
  v_subrev_f32 v37, s60, v29
  v_subrev_f32 v38, s60, v30
  v_subrev_f32 v39, s60, v31
  v_subrev_f32 v40, s60, v32
  v_subrev_f32 v41, s60, v33
  v_subrev_f32 v42, s60, v34
  v_subrev_f32 v43, s60, v35
  v_add_f32 v44, v36, v37
  v_mul_f32 v46, v36, v36
  v_add_f32 v45, v38, v39
  v_mul_f32 v47, v37, v37
  v_add_f32 v48, v40, v41
  v_fmac_f32 v46, v38, v38
  v_add_f32 v49, v42, v43
  v_fmac_f32 v47, v39, v39
  v_add_f32 v44, v44, v45
  v_fmac_f32 v46, v40, v40
  v_add_f32 v48, v48, v49
  v_fmac_f32 v47, v41, v41
  v_fmac_f32 v46, v42, v42
  v_fmac_f32 v47, v43, v43
  v_add_f32 v44, v44, v48
  v_add_f32 v46, v46, v47
  s_nop 0
  v_add_f32_dpp v44, v44, v44 row_ror:8 row_mask:0xf bank_mask:0xf
  v_add_f32_dpp v46, v46, v46 row_ror:8 row_mask:0xf bank_mask:0xf
  s_nop 0
  v_add_f32_dpp v44, v44, v44 row_ror:4 row_mask:0xf bank_mask:0xf
  v_add_f32_dpp v46, v46, v46 row_ror:4 row_mask:0xf bank_mask:0xf
  s_nop 0
  v_add_f32_dpp v44, v44, v44 row_ror:2 row_mask:0xf bank_mask:0xf
  v_add_f32_dpp v46, v46, v46 row_ror:2 row_mask:0xf bank_mask:0xf
  s_nop 0
  v_add_f32_dpp v44, v44, v44 row_ror:1 row_mask:0xf bank_mask:0xf
  v_add_f32_dpp v46, v46, v46 row_ror:1 row_mask:0xf bank_mask:0xf
  v_mov_b32 v45, v44
  v_mov_b32 v47, v46
  s_nop 0
  v_permlane16_swap_b32 v45, v44
  v_permlane16_swap_b32 v47, v46
  v_add_f32 v44, v44, v45
  v_add_f32 v46, v46, v47
  v_mov_b32 v45, v44
  v_mov_b32 v47, v46
  s_nop 0
  v_permlane32_swap_b32 v45, v44
  v_permlane32_swap_b32 v47, v46
  v_add_f32 v44, v44, v45
  v_add_f32 v46, v46, v47
  v_mul_f32 v44, 0x3b000000, v44
  v_mul_f32 v46, 0x3b000000, v46
  v_fma_f32 v46, -v44, v44, v46
  v_add_f32 v44, s60, v44
  v_max_f32 v46, 0, v46
  v_cvt_pk_bf16_f32 v47, v44, v46
  v_lshlrev_b32 v44, 16, v47
  v_and_b32 v46, 0xffff0000, v47
  v_add_f32 v46, 0x3727c5ac, v46
  v_sub_f32 v36, v28, v44
  v_sub_f32 v37, v29, v44
  v_cvt_pk_bf16_f32 v47, v46, v46
  v_sub_f32 v38, v30, v44
  v_sub_f32 v39, v31, v44
  v_lshlrev_b32 v46, 16, v47
  v_sub_f32 v40, v32, v44
  v_sub_f32 v41, v33, v44
  v_sqrt_f32 v46, v46
  v_sub_f32 v42, v34, v44
  v_sub_f32 v43, v35, v44
  v_cvt_pk_bf16_f32 v48, v36, v37
  v_cvt_pk_bf16_f32 v47, v46, v46
  v_cvt_pk_bf16_f32 v49, v38, v39
  v_lshlrev_b32 v46, 16, v47
  v_cvt_pk_bf16_f32 v50, v40, v41
  v_rcp_f32 v45, v46
  v_cvt_pk_bf16_f32 v51, v42, v43
  v_lshlrev_b32 v36, 16, v48
  v_and_b32 v37, 0xffff0000, v48
  v_lshlrev_b32 v38, 16, v49
  v_and_b32 v39, 0xffff0000, v49
  v_lshlrev_b32 v40, 16, v50
  v_and_b32 v41, 0xffff0000, v50
  v_lshlrev_b32 v42, 16, v51
  v_and_b32 v43, 0xffff0000, v51
  v_mul_f32 v28, v36, v45
  v_mul_f32 v29, v37, v45
  v_mul_f32 v30, v38, v45
  v_mul_f32 v31, v39, v45
  v_mul_f32 v32, v40, v45
  v_mul_f32 v33, v41, v45
  v_mul_f32 v34, v42, v45
  v_mul_f32 v35, v43, v45
  v_fma_f32 v36, -v28, v46, v36
  v_fma_f32 v37, -v29, v46, v37
  v_fma_f32 v38, -v30, v46, v38
  v_fma_f32 v39, -v31, v46, v39
  v_fma_f32 v40, -v32, v46, v40
  v_fma_f32 v41, -v33, v46, v41
  v_fma_f32 v42, -v34, v46, v42
  v_fma_f32 v43, -v35, v46, v43
  v_fmac_f32 v28, v36, v45
  v_fmac_f32 v29, v37, v45
  v_fmac_f32 v30, v38, v45
  v_fmac_f32 v31, v39, v45
  v_fmac_f32 v32, v40, v45
  v_fmac_f32 v33, v41, v45
  v_fmac_f32 v34, v42, v45
  v_fmac_f32 v35, v43, v45
  v_cvt_pk_bf16_f32 v48, v28, v29
  v_cvt_pk_bf16_f32 v49, v30, v31
  v_cvt_pk_bf16_f32 v50, v32, v33
  v_cvt_pk_bf16_f32 v51, v34, v35
  ds_write_b128 v4, v[48:51]
  s_mov_b64 exec, 1
  ds_write_b32 v7, v61 offset:256
  s_mov_b64 exec, -1
  s_setprio 0
  s_waitcnt lgkmcnt(0)
  s_add_u32 s30, s30, 16
  buffer_load_dwordx4 v[64:67], v5, s[32:35], s89 offen sc1
L_spin0:
  ds_read_b32 v125, v7 offset:260
  s_sub_u32 s82, s82, 1
  s_waitcnt lgkmcnt(0)
  v_readfirstlane_b32 s80, v125
  s_cmp_ge_u32 s80, 1024
  s_cbranch_scc1 L_spin0_done
  s_cmp_gt_i32 s82, 0
  s_cbranch_scc1 L_spin0
L_spin0_done:
  s_cmp_eq_u32 s80, 0x400
  s_cselect_b32 s89, s89, s73
  s_cmp_ge_u32 s79, 89
  s_cbranch_scc1 L_spin1_done
L_spin1:
  ds_read_b32 v125, v7 offset:0
  s_sub_u32 s82, s82, 1
  s_waitcnt lgkmcnt(0)
  v_readfirstlane_b32 s79, v125
  s_cmp_ge_u32 s79, 89
  s_cbranch_scc1 L_spin1_done
  s_cmp_gt_i32 s82, 0
  s_cbranch_scc1 L_spin1
L_spin1_done:
  buffer_load_dwordx4 v[64:67], v5, s[32:35], s89 offen sc1
L_ml_loop:
  s_add_u32 s78, s78, 1
  s_and_b32 s60, s78, 31
  s_cmp_eq_u32 s60, 0
  s_cselect_b32 s60, s73, s89
  s_sub_u32 s82, s82, 1
  s_waitcnt vmcnt(0)
  v_cmp_ne_u32 vcc, s30, v67
  v_cmp_ne_u32 s[44:45], s30, v66
  v_mov_b32 v32, v64
  v_mov_b32 v33, v65
  s_or_b64 vcc, vcc, s[44:45]
  s_cbranch_scc0 L_ml_done
  s_mov_b64 exec, vcc
  buffer_load_dwordx4 v[64:67], v5, s[32:35], s60 offen sc1
  s_mov_b64 exec, -1
  s_cmp_gt_i32 s82, 0
  s_cbranch_scc1 L_ml_loop
L_ml_done:
  v_mov_b32 v36, v32
  s_nop 1
  v_max_f32_dpp v36, v36, v36 row_ror:8 row_mask:0xf bank_mask:0xf
  s_nop 1
  v_max_f32_dpp v36, v36, v36 row_ror:4 row_mask:0xf bank_mask:0xf
  s_nop 1
  v_max_f32_dpp v36, v36, v36 row_ror:2 row_mask:0xf bank_mask:0xf
  s_nop 1
  v_max_f32_dpp v36, v36, v36 row_ror:1 row_mask:0xf bank_mask:0xf
  v_mov_b32 v37, v36
  s_nop 1
  v_permlane16_swap_b32 v37, v36
  v_max_f32 v36, v36, v37
  v_sub_f32 v37, v32, v36
  v_mul_f32 v37, 0x3fb8aa3b, v37
  v_exp_f32 v37, v37
  s_nop 0
  v_mul_f32 v38, v37, v33
  s_nop 1
  v_add_f32_dpp v38, v38, v38 row_ror:8 row_mask:0xf bank_mask:0xf
  s_nop 1
  v_add_f32_dpp v38, v38, v38 row_ror:4 row_mask:0xf bank_mask:0xf
  s_nop 1
  v_add_f32_dpp v38, v38, v38 row_ror:2 row_mask:0xf bank_mask:0xf
  s_nop 1
  v_add_f32_dpp v38, v38, v38 row_ror:1 row_mask:0xf bank_mask:0xf
  v_mov_b32 v39, v38
  s_nop 1
  v_permlane16_swap_b32 v39, v38
  v_add_f32 v38, v38, v39
  v_rcp_f32 v39, v38
  s_nop 0
  v_mul_f32 v42, v37, v39
  v_fma_f32 v43, -v42, v38, v37
  v_fmac_f32 v42, v43, v39
  s_mov_b64 exec, 0xffffffff
  ds_write_b32 v60, v42
  s_mov_b64 exec, 1
  ds_write_b32 v7, v61 offset:280
  s_mov_b64 exec, -1
  s_waitcnt lgkmcnt(0)
  s_endpgm
.p2align 12
L_g:
  s_and_b32 s28, s2, 7
  s_lshr_b32 s29, s2, 3
  v_and_b32 v1, 15, v0
  v_lshrrev_b32 v2, 4, v0
  v_mov_b32 v7, 126208
  s_mov_b32 s82, 400000
  s_mov_b32 s79, 0
  s_mov_b32 s59, s2
  s_mul_i32 s63, s59, 4682
  s_lshr_b32 s63, s63, 16
  s_mul_i32 s64, s63, 14
  s_sub_u32 s64, s59, s64
  s_lshr_b32 s70, s29, 1
  s_lshl_b32 s71, s28, 4
  s_add_u32 s70, s70, s71
  s_and_b32 s71, s29, 1
  s_mov_b32 s83, 0x07060501
  s_mov_b32 s84, 0x07060502
  s_mov_b32 s85, 0x07060503
  s_mov_b32 s86, 0x0c04000c
  s_mov_b32 s87, 0x04020100
  s_waitcnt lgkmcnt(0)
  s_load_dword s30, s[26:27], 0
  s_barrier
  s_mov_b32 s32, s26
  s_and_b32 s33, s27, 0xffff
  s_mov_b32 s34, 1982464
  s_mov_b32 s35, 0x20000
  s_sub_u32 s3, s3, 2
  s_min_u32 s65, s63, 15
  s_lshl_b32 s65, s65, 6
  s_add_u32 s65, s65, 122880
  v_lshl_add_u32 v3, v2, 4, s65
  v_lshrrev_b32 v100, 2, v1
  v_and_b32 v101, 1, v2
  v_bfe_u32 v102, v1, 1, 1
  v_and_b32 v103, 1, v1
  v_lshrrev_b32 v104, 1, v0
  v_lshlrev_b32 v11, 11, v104
  v_lshl_add_u32 v11, v103, 4, v11
  v_lshlrev_b32 v9, 2, v104
  v_add_u32 v9, 126720, v9
  s_lshl_b32 s74, s28, 16
  s_lshr_b32 s75, s29, 1
  s_lshl_b32 s75, s75, 7
  s_add_u32 s74, s74, s75
  s_lshl_b32 s75, s3, 5
  s_add_u32 s74, s74, s75
  s_add_u32 s75, s74, 851968
  s_add_u32 s74, s74, 327680
  s_cmp_lg_u32 s3, 3
  s_cbranch_scc1 L_g_noptq
  s_lshl_b32 s60, s28, 13
  s_xor_b32 s61, s29, 1
  s_lshl_b32 s61, s61, 8
  s_add_u32 s60, s60, s61
  s_add_u32 s60, s60, 1916928
  v_lshlrev_b32 v24, 7, v0
  s_mov_b64 exec, 3
  buffer_load_dword v124, v24, s[32:35], s60 offen sc1
  s_mov_b64 exec, -1
L_g_noptq:
  s_mul_i32 s76, s70, 7
  v_and_b32 v8, 7, v0
  s_andn2_b32 s76, s76, 1
  v_add_u32 v8, s76, v8
  v_lshrrev_b32 v105, 6, v8
  v_and_b32 v8, 63, v8
  v_lshlrev_b32 v8, 4, v8
  v_lshl_add_u32 v8, v105, 14, v8
  v_lshrrev_b32 v105, 3, v0
  v_lshl_add_u32 v8, v105, 10, v8
  s_mov_b32 s78, 86016
  s_mov_b32 s81, 94208
  v_lshl_or_b32 v104, v101, 2, v100
  s_lshl_b32 s60, s3, 2
  v_add_u32 v105, s60, v102
  v_lshlrev_b32 v104, 1, v104
  v_xor_b32 v105, v105, v104
  v_lshlrev_b32 v105, 4, v105
  v_lshl_add_u32 v105, v103, 3, v105
  v_lshl_add_u32 v104, v2, 3, v100
  v_lshl_add_u32 v4, v104, 8, v105
  v_add_u32 v4, 81920, v4
  v_xor_b32 v5, 32, v4
  s_lshl_b32 s60, s3, 8
  v_lshl_add_u32 v6, v0, 3, s60
  s_lshl_b32 s60, s64, 14
  s_lshl_b32 s61, s63, 10
  s_add_u32 s60, s60, s61
  s_add_u32 s77, s60, 86016
  v_lshl_add_u32 v104, v2, 2, v100
  v_subrev_u32 v105, 2, v104
  v_cmp_lt_u32 vcc, 13, v104
  s_nop 1
  v_cndmask_b32 v104, v104, v105, vcc
  v_and_b32 v105, 7, v104
  v_lshlrev_b32 v105, 1, v105
  s_lshl_b32 s60, s3, 3
  v_add_u32 v106, s60, v102
  v_xor_b32 v105, v105, v106
  v_lshlrev_b32 v105, 4, v105
  v_lshl_add_u32 v105, v103, 3, v105
  v_lshl_add_u32 v12, v104, 9, v105
  v_add_u32 v12, 114688, v12
  v_xor_b32 v13, 32, v12
  v_xor_b32 v14, 64, v12
  v_xor_b32 v15, 0x60, v12
  v_lshrrev_b32 v104, 3, v1
  v_and_b32 v105, 1, v100
  v_lshl_or_b32 v107, v105, 1, v104
  v_lshl_or_b32 v107, v101, 2, v107
  v_lshl_add_u32 v104, v105, 2, v104
  v_lshl_add_u32 v104, v2, 3, v104
  v_lshlrev_b32 v107, 1, v107
  v_xor_b32 v107, v107, v106
  v_lshlrev_b32 v107, 4, v107
  v_lshl_add_u32 v107, v103, 3, v107
  v_lshl_add_u32 v16, v104, 9, v107
  v_add_u32 v16, 98304, v16
  v_xor_b32 v17, 32, v16
  v_xor_b32 v18, 64, v16
  v_xor_b32 v19, 0x60, v16
  v_lshrrev_b32 v104, 1, v2
  v_lshl_or_b32 v104, v101, 1, v104
  s_lshl_b32 s60, s3, 4
  s_add_u32 s60, s60, 126528
  v_lshl_add_u32 v20, v104, 2, s60
  v_lshlrev_b32 v21, 4, v2
  v_add_u32 v21, 126528, v21
  v_lshrrev_b32 v104, 2, v0
  v_lshlrev_b32 v22, 13, v104
  v_and_b32 v104, 3, v0
  v_lshl_add_u32 v22, v104, 4, v22
  s_lshl_b32 s60, s71, 18
  s_lshl_b32 s61, s3, 16
  s_add_u32 s60, s60, s61
  s_lshl_b32 s61, s70, 6
  s_add_u32 s60, s60, s61
  s_add_u32 s76, s60, 1376256
  s_mov_b32 s62, 0xffff0000
  s_mov_b32 s63, 0xffff0000
  v_mov_b32 v23, 1
  s_waitcnt lgkmcnt(0)
  s_add_u32 s30, s30, 16
  s_cmp_eq_u32 s3, 1
  s_cbranch_scc1 L_touch
L_touch_ret:
  s_cmp_ge_u32 s59, 224
  s_cbranch_scc1 L_g_nogu
L_spin2:
  ds_read_b32 v125, v7 offset:256
  s_sub_u32 s82, s82, 1
  s_waitcnt lgkmcnt(0)
  v_readfirstlane_b32 s80, v125
  s_cmp_ge_u32 s80, 1
  s_cbranch_scc1 L_spin2_done
  s_cmp_gt_i32 s82, 0
  s_cbranch_scc1 L_spin2
L_spin2_done:
  ds_read_b128 v[44:47], v3
L_spin3:
  ds_read_b32 v125, v7 offset:0
  s_sub_u32 s82, s82, 1
  s_waitcnt lgkmcnt(0)
  v_readfirstlane_b32 s79, v125
  s_cmp_ge_u32 s79, 24
  s_cbranch_scc1 L_spin3_done
  s_cmp_gt_i32 s82, 0
  s_cbranch_scc1 L_spin3
L_spin3_done:
  ds_read_b64_tr_b16 v[48:49], v4 offset:0
  ds_read_b64_tr_b16 v[50:51], v4 offset:1024
  ds_read_b64_tr_b16 v[56:57], v5 offset:0
  ds_read_b64_tr_b16 v[58:59], v5 offset:1024
  ds_read_b64_tr_b16 v[52:53], v4 offset:8192
  ds_read_b64_tr_b16 v[54:55], v4 offset:9216
  ds_read_b64_tr_b16 v[60:61], v5 offset:8192
  ds_read_b64_tr_b16 v[62:63], v5 offset:9216
  s_waitcnt lgkmcnt(0)
  v_mfma_f32_16x16x32_bf16 v[64:67], v[44:47], v[48:51], 0
  v_mfma_f32_16x16x32_bf16 v[68:71], v[44:47], v[52:55], 0
  v_mfma_f32_16x16x32_bf16 v[72:75], v[44:47], v[56:59], 0
  v_mfma_f32_16x16x32_bf16 v[76:79], v[44:47], v[60:63], 0
  v_mov_b32 v83, s30
  s_nop 5
  v_cndmask_b32 v64, v64, v72, s[62:63]
  v_cndmask_b32 v68, v68, v76, s[62:63]
  s_nop 0
  v_mov_b32_dpp v65, v64 quad_perm:[1,0,3,2] row_mask:0xf bank_mask:0xf
  v_mov_b32_dpp v69, v68 quad_perm:[1,0,3,2] row_mask:0xf bank_mask:0xf
  v_perm_b32 v80, v64, v69, s83
  v_perm_b32 v81, v68, v69, s84
  v_perm_b32 v82, v65, v69, s85
  s_mov_b64 exec, 0x55555555
  buffer_store_dwordx4 v[80:83], v6, s[32:35], s77 offen sc1
  s_mov_b64 exec, -1
L_g_nogu:
  s_nop 7
  s_nop 3
  s_cmp_eq_u32 s3, 0
  s_cbranch_scc1 L_g_hf
  s_cmp_lg_u32 s3, 2
  s_cbranch_scc1 L_g_join
  s_mov_b32 s60, 0x55555555
  s_mov_b32 s61, 0x55555555
  s_mov_b64 exec, s[60:61]
  buffer_load_dword v24, v11, s[32:35], s75 offen sc1
  s_mov_b64 exec, -1
  s_branch L_g_join
L_g_hf:
  s_mov_b64 s[66:67], -1
  s_mov_b64 s[68:69], -1
  s_and_b32 s60, s70, 1
  v_subrev_u32 v36, s60, v0
  v_and_b32 v36, 7, v36
  v_lshlrev_b32 v37, 2, v36
  v_lshl_add_u32 v37, v2, 1, v37
  v_add_u32 v37, 126080, v37
  v_cmp_eq_u32 s[60:61], 7, v36
  s_cmp_ge_u32 s79, 64
  s_cbranch_scc1 L_spin4_done
L_spin4:
  ds_read_b32 v125, v7 offset:0
  s_sub_u32 s82, s82, 1
  s_waitcnt lgkmcnt(0)
  v_readfirstlane_b32 s79, v125
  s_cmp_ge_u32 s79, 64
  s_cbranch_scc1 L_spin4_done
  s_cmp_gt_i32 s82, 0
  s_cbranch_scc1 L_spin4
L_spin4_done:
L_hf_loop:
  s_wqm_b64 exec, s[66:67]
  buffer_load_dwordx4 v[24:27], v8, s[32:35], s78 offen sc1
  s_wqm_b64 exec, s[68:69]
  buffer_load_dwordx4 v[28:31], v8, s[32:35], s81 offen sc1
  s_mov_b64 exec, -1
  s_sub_u32 s82, s82, 1
  s_waitcnt vmcnt(0)
  v_cmp_ne_u32 s[66:67], s30, v27
  v_cmp_ne_u32 s[68:69], s30, v31
  s_or_b64 vcc, s[66:67], s[68:69]
  s_cmp_eq_u64 vcc, 0
  s_cbranch_scc1 L_hf_done
  s_cmp_gt_i32 s82, 0
  s_cbranch_scc1 L_hf_loop
L_hf_done:
  v_perm_b32 v27, v25, v24, s86
  v_perm_b32 v27, v26, v27, s87
  v_perm_b32 v31, v29, v28, s86
  v_perm_b32 v31, v30, v31, s87
  v_add_f32 v24, v24, v28
  v_add_f32 v25, v25, v29
  v_add_f32 v26, v26, v30
  v_add_f32 v27, v27, v31
  v_permlane32_swap_b32 v24, v25
  s_nop 0
  v_permlane32_swap_b32 v26, v27
  v_add_f32 v24, v24, v25
  v_add_f32 v26, v26, v27
  s_nop 1
  v_permlane16_swap_b32 v24, v26
  v_add_f32 v24, v24, v26
  s_nop 1
  v_add_f32_dpp v24, v24, v24 row_ror:8 row_mask:0xf bank_mask:0xf
  v_cvt_pk_bf16_f32 v24, v24, v24
  v_lshlrev_b32 v24, 16, v24
  v_mov_b32 v25, v24
  v_mov_b32 v26, v24
  s_nop 1
  v_permlane32_swap_b32 v26, v25
  v_mul_f32 v28, v24, v24
  v_mov_b32 v29, 0x40135761
  v_fmac_f32 v29, 0x3dd2d3e8, v28
  v_mul_f32 v29, v29, v24
  v_min_f32 v29, 0x42a00000, v29
  v_exp_f32 v29, v29
  s_nop 0
  v_add_f32 v28, 1.0, v29
  v_rcp_f32 v28, v28
  s_nop 0
  v_mul_f32 v29, v29, v28
  v_mul_f32 v29, v29, v24
  v_cvt_pk_bf16_f32 v29, v29, v29
  v_lshlrev_b32 v29, 16, v29
  v_mul_f32 v29, v29, v25
  v_cvt_pk_bf16_f32 v29, v29, v29
  v_cndmask_b32 v29, v29, 0, s[60:61]
  s_mov_b64 exec, 0x00ff00ff
  ds_write_b16 v37, v29
  s_mov_b64 exec, 1
  ds_write_b32 v7, v23 offset:276
  s_mov_b64 exec, -1
  s_branch L_g_join
L_g_join:
  s_nop 7
  s_nop 3
  v_lshlrev_b32 v36, 3, v2
  v_add_u32 v36, 126080, v36
  v_mov_b32 v107, s30
  s_mov_b32 s68, 0x00010001
  s_mov_b32 s69, 0x00010001
  s_mov_b32 s60, 0
L_spin5:
  ds_read_b32 v125, v7 offset:260
  s_sub_u32 s82, s82, 1
  s_waitcnt lgkmcnt(0)
  v_readfirstlane_b32 s80, v125
  s_cmp_ge_u32 s80, 1024
  s_cbranch_scc1 L_spin5_done
  s_cmp_gt_i32 s82, 0
  s_cbranch_scc1 L_spin5
L_spin5_done:
  s_cmp_eq_u32 s80, 0x400
  s_cselect_b32 s81, s75, s74
  s_cmp_ge_u32 s79, 92
  s_cbranch_scc1 L_spin6_done
L_spin6:
  ds_read_b32 v125, v7 offset:0
  s_sub_u32 s82, s82, 1
  s_waitcnt lgkmcnt(0)
  v_readfirstlane_b32 s79, v125
  s_cmp_ge_u32 s79, 92
  s_cbranch_scc1 L_spin6_done
  s_cmp_gt_i32 s82, 0
  s_cbranch_scc1 L_spin6
L_spin6_done:
  ds_read_b64_tr_b16 v[48:49], v12
  ds_read_b64_tr_b16 v[50:51], v13
  ds_read_b64_tr_b16 v[52:53], v14
  ds_read_b64_tr_b16 v[54:55], v15
L_spin7:
  ds_read_b32 v125, v7 offset:276
  s_sub_u32 s82, s82, 1
  s_waitcnt lgkmcnt(0)
  v_readfirstlane_b32 s80, v125
  s_cmp_ge_u32 s80, 1
  s_cbranch_scc1 L_spin7_done
  s_cmp_gt_i32 s82, 0
  s_cbranch_scc1 L_spin7
L_spin7_done:
  ds_read_b64 v[44:45], v36
  s_waitcnt lgkmcnt(0)
  v_mfma_f32_16x16x16_bf16 v[56:59], v[44:45], v[48:49], 0
  v_mfma_f32_16x16x16_bf16 v[60:63], v[44:45], v[50:51], 0
  v_mfma_f32_16x16x16_bf16 v[64:67], v[44:45], v[52:53], 0
  v_mfma_f32_16x16x16_bf16 v[68:71], v[44:45], v[54:55], 0
  s_cmp_ge_u32 s79, 99
  s_cbranch_scc1 L_spin8_done
L_spin8:
  ds_read_b32 v125, v7 offset:0
  s_sub_u32 s82, s82, 1
  s_waitcnt lgkmcnt(0)
  v_readfirstlane_b32 s79, v125
  s_cmp_ge_u32 s79, 99
  s_cbranch_scc1 L_spin8_done
  s_cmp_gt_i32 s82, 0
  s_cbranch_scc1 L_spin8
L_spin8_done:
  buffer_load_dwordx4 v[128:131], v11, s[32:35], s81 offen sc1
  s_cmp_ge_u32 s79, 101
  s_cbranch_scc1 L_spin9_done
L_spin9:
  ds_read_b32 v125, v7 offset:0
  s_sub_u32 s82, s82, 1
  s_waitcnt lgkmcnt(0)
  v_readfirstlane_b32 s79, v125
  s_cmp_ge_u32 s79, 101
  s_cbranch_scc1 L_spin9_done
  s_cmp_gt_i32 s82, 0
  s_cbranch_scc1 L_spin9
L_spin9_done:
  ds_read_b64_tr_b16 v[72:73], v16
  ds_read_b64_tr_b16 v[74:75], v16 offset:1024
  ds_read_b64_tr_b16 v[76:77], v17
  ds_read_b64_tr_b16 v[78:79], v17 offset:1024
  ds_read_b64_tr_b16 v[80:81], v18
  ds_read_b64_tr_b16 v[82:83], v18 offset:1024
  ds_read_b64_tr_b16 v[84:85], v19
  ds_read_b64_tr_b16 v[86:87], v19 offset:1024
  v_cndmask_b32 v56, v56, v64, s[62:63]
  v_cndmask_b32 v60, v60, v68, s[62:63]
L_h2_loop:
  ds_read_b32 v125, v7 offset:280
  ds_read_b32 v46, v9
  s_add_u32 s60, s60, 1
  s_and_b32 s61, s60, 31
  s_cmp_eq_u32 s61, 0
  s_cselect_b32 s61, s74, s81
  s_sub_u32 s82, s82, 1
  s_waitcnt vmcnt(0) lgkmcnt(0)
  v_cmp_ne_u32 vcc, s30, v131
  v_readfirstlane_b32 s80, v125
  v_perm_b32 v27, v129, v128, s86
  v_mul_f32 v32, v46, v128
  v_mul_f32 v33, v46, v129
  v_perm_b32 v27, v130, v27, s87
  v_mov_b32 v26, v130
  v_mov_b32 v24, v128
  v_mov_b32 v25, v129
  s_cbranch_vccz L_h2_done
  s_wqm_b64 exec, vcc
  buffer_load_dwordx4 v[128:131], v11, s[32:35], s61 offen sc1
  s_mov_b64 exec, -1
  s_cmp_gt_i32 s82, 0
  s_cbranch_scc1 L_h2_loop
L_h2_done:
  s_cmp_ge_u32 s80, 1
  s_cbranch_scc1 L_ff_done
L_ff_loop:
  ds_read_b32 v125, v7 offset:280
  ds_read_b32 v46, v9
  s_sub_u32 s82, s82, 1
  s_waitcnt lgkmcnt(0)
  v_readfirstlane_b32 s80, v125
  v_mul_f32 v32, v46, v24
  v_mul_f32 v33, v46, v25
  s_cmp_ge_u32 s80, 1
  s_cbranch_scc1 L_ff_done
  s_cmp_gt_i32 s82, 0
  s_cbranch_scc1 L_ff_loop
L_ff_done:
  v_mul_f32 v26, v46, v26
  v_mul_f32 v27, v46, v27
  v_permlane32_swap_b32 v32, v33
  s_nop 0
  v_permlane32_swap_b32 v26, v27
  v_add_f32 v24, v32, v33
  v_add_f32 v26, v26, v27
  s_nop 1
  v_permlane16_swap_b32 v24, v26
  v_add_f32 v24, v24, v26
  s_nop 1
  v_add_f32_dpp v24, v24, v24 row_ror:8 row_mask:0xf bank_mask:0xf
  s_nop 1
  v_add_f32_dpp v24, v24, v24 row_ror:4 row_mask:0xf bank_mask:0xf
  s_nop 1
  v_add_f32_dpp v24, v24, v24 row_ror:2 row_mask:0xf bank_mask:0xf
  s_nop 1
  v_mov_b32_dpp v25, v24 quad_perm:[1,0,3,2] row_mask:0xf bank_mask:0xf
  v_cvt_pk_bf16_f32 v24, v24, v25
  s_mov_b64 exec, s[68:69]
  ds_write_b32 v20, v24
  s_mov_b64 exec, 1
  ds_add_u32 v7, v23 offset:284
  s_mov_b64 exec, -1
L_ov_loop:
  ds_read_b128 v[28:31], v21
  s_sub_u32 s82, s82, 1
  s_waitcnt lgkmcnt(0)
  v_max3_u32 v32, v28, v29, v30
  v_max_u32 v32, v32, v31
  v_cmp_eq_u32 vcc, -1, v32
  s_cbranch_vccz L_ov_done
  s_cmp_gt_i32 s82, 0
  s_cbranch_scc1 L_ov_loop
L_ov_done:
  v_mfma_f32_16x16x32_bf16 v[88:91], v[28:31], v[72:75], 0
  v_mfma_f32_16x16x32_bf16 v[92:95], v[28:31], v[76:79], 0
  v_mfma_f32_16x16x32_bf16 v[96:99], v[28:31], v[80:83], 0
  v_mfma_f32_16x16x32_bf16 v[100:103], v[28:31], v[84:87], 0
  s_nop 6
  v_cndmask_b32 v88, v88, v96, s[62:63]
  v_cndmask_b32 v92, v92, v100, s[62:63]
  v_perm_b32 v104, v88, v60, s83
  v_perm_b32 v105, v56, v60, s84
  v_perm_b32 v106, v92, v60, s85
  s_mov_b64 exec, 0xffffffff
  buffer_store_dwordx4 v[104:107], v22, s[32:35], s76 offen sc1
  s_mov_b64 exec, 1
  ds_add_u32 v7, v23 offset:272
  s_waitcnt lgkmcnt(0)
  s_endpgm
L_touch:
  s_branch L_touch_ret
L_final:
  s_mov_b32 s40, s22
  s_and_b32 s41, s23, 0xffff
  s_mov_b32 s42, 1024
  s_mov_b32 s43, 0x20000
  s_lshl_b32 s77, s28, 2
  s_lshl_b32 s76, s29, 3
  s_add_u32 s77, s77, s76
  v_lshlrev_b32 v3, 4, v0
  s_add_u32 s72, s77, s3
  s_lshl_b32 s72, s72, 11
  s_add_u32 s72, s72, 1376256
  s_lshr_b32 s75, s77, 4
  s_lshl_b32 s75, s75, 6
  s_lshr_b32 s76, s77, 2
  s_and_b32 s76, s76, 3
  s_lshl_b32 s76, s76, 3
  s_add_u32 s75, s75, s76
  v_and_b32 v9, 3, v0
  v_and_b32 v8, 1, v2
  v_lshlrev_b32 v8, 5, v8
  v_lshl_add_u32 v8, v9, 1, v8
  s_add_u32 s76, s75, 126976
  v_add_u32 v11, s76, v8
  ds_read_u16 v10, v11
  v_lshl_add_u32 v11, v2, 2, v9
  v_lshlrev_b32 v11, 4, v11
  v_add_u32 v11, 128000, v11
  s_lshl_b32 s76, s3, 2
  v_add_u32 v9, s76, v11
L_spin23:
  ds_read_b32 v125, v7 offset:272
  s_sub_u32 s82, s82, 1
  s_waitcnt lgkmcnt(0)
  v_readfirstlane_b32 s80, v125
  s_cmp_ge_u32 s80, 4
  s_cbranch_scc1 L_spin23_done
  s_cmp_gt_i32 s82, 0
  s_cbranch_scc1 L_spin23
L_spin23_done:
  buffer_load_dwordx4 v[64:67], v3, s[32:35], s72 offen offset:0 sc1
  buffer_load_dwordx4 v[68:71], v3, s[32:35], s72 offen offset:1024 sc1
  s_waitcnt lgkmcnt(0)
L_f_loop:
  s_sub_u32 s82, s82, 1
  s_waitcnt vmcnt(0)
  v_cmp_ne_u32 s[44:45], s30, v67
  v_cmp_ne_u32 s[46:47], s30, v71
  v_perm_b32 v15, v65, v64, s86
  v_perm_b32 v20, v69, v68, s86
  v_add_f32 v12, v64, v68
  v_add_f32 v13, v65, v69
  v_perm_b32 v15, v66, v15, s87
  v_perm_b32 v20, v70, v20, s87
  v_add_f32 v14, v66, v70
  s_or_b64 vcc, s[44:45], s[46:47]
  s_cbranch_scc0 L_f_done
  s_wqm_b64 exec, s[44:45]
  buffer_load_dwordx4 v[64:67], v3, s[32:35], s72 offen sc1
  s_wqm_b64 exec, s[46:47]
  buffer_load_dwordx4 v[68:71], v3, s[32:35], s72 offen offset:1024 sc1
  s_mov_b64 exec, -1
  s_cmp_gt_i32 s82, 0
  s_cbranch_scc1 L_f_loop
L_f_done:
  v_add_f32 v15, v15, v20
  v_permlane32_swap_b32 v12, v13
  v_lshlrev_b32 v24, 16, v10
  v_permlane32_swap_b32 v14, v15
  v_add_f32 v12, v12, v13
  v_add_f32 v14, v14, v15
  s_nop 1
  v_permlane16_swap_b32 v12, v14
  v_add_f32 v12, v12, v14
  s_nop 1
  v_add_f32_dpp v12, v12, v12 row_ror:8 row_mask:0xf bank_mask:0xf
  s_nop 1
  v_add_f32_dpp v12, v12, v12 row_ror:4 row_mask:0xf bank_mask:0xf
  s_mov_b64 exec, s[62:63]
  ds_write_b32 v9, v12
  s_mov_b64 exec, 1
  ds_add_rtn_u32 v13, v7, v16 offset:288
  s_mov_b64 exec, -1
  ds_read_b128 v[20:23], v11
  s_waitcnt lgkmcnt(0)
  v_readfirstlane_b32 s60, v13
  v_add_f32 v20, v20, v21
  v_add_f32 v22, v22, v23
  s_cmp_lg_u32 s60, 3
  s_cbranch_scc1 L_fin
  v_add_f32 v12, v20, v22
  v_cvt_pk_bf16_f32 v13, v12, v12
  v_lshlrev_b32 v12, 16, v13
  v_mul_f32 v13, 0xbfb8aa3b, v12
  v_exp_f32 v13, v13
  s_nop 0
  v_add_f32 v13, 1.0, v13
  v_rcp_f32 v13, v13
  s_nop 0
  v_mul_f32 v13, v12, v13
  v_cvt_pk_bf16_f32 v13, v13, v13
  v_lshlrev_b32 v13, 16, v13
  v_mov_b32 v14, v13
  s_nop 1
  v_permlane32_swap_b32 v13, v14
  v_mul_f32 v12, v12, v14
  v_cvt_pk_bf16_f32 v12, v12, v12
  v_lshlrev_b32 v12, 16, v12
  v_add_f32 v12, v24, v12
  v_cvt_pk_bf16_f32 v12, v12, v12
  v_mov_b32 v13, s30
  s_mov_b64 exec, 0x000f000f
  buffer_store_short v12, v8, s[40:43], s75 offen
  s_cmp_lg_u32 s2, 0
  s_cbranch_scc1 L_fin
  s_mov_b64 exec, 1
  buffer_store_dword v13, off, s[32:35], 0
L_fin:
  s_endpgm
.p2align 12
L_att:
  s_and_b32 s28, s2, 7
  s_lshr_b32 s29, s2, 3
  v_and_b32 v1, 15, v0
  v_lshrrev_b32 v2, 4, v0
  v_mov_b32 v7, 126208
  s_mov_b32 s82, 400000
  s_mov_b32 s79, 0
  s_mov_b32 s83, 0x07060501
  s_mov_b32 s84, 0x07060502
  s_mov_b32 s85, 0x07060503
  s_mov_b32 s86, 0x0c04000c
  s_mov_b32 s87, 0x04020100
  s_sub_u32 s3, s3, 6
  s_lshr_b32 s65, s29, 3
  s_lshl_b32 s65, s65, 8
  s_add_u32 s65, s65, 122880
  v_lshl_add_u32 v5, v2, 4, s65
  v_lshrrev_b32 v100, 2, v1
  v_lshl_add_u32 v100, v2, 3, v100
  v_lshrrev_b32 v101, 3, v1
  v_and_b32 v102, 1, v2
  v_lshl_or_b32 v101, v102, 1, v101
  v_bfe_u32 v102, v1, 1, 1
  v_lshl_or_b32 v101, v101, 1, v102
  v_lshlrev_b32 v101, 4, v101
  v_and_b32 v102, 1, v1
  v_lshl_add_u32 v101, v102, 3, v101
  v_lshl_add_u32 v120, v100, 7, v101
  s_lshl_b32 s60, s3, 5
  v_xor_b32 v120, s60, v120
  v_lshlrev_b32 v121, 4, v2
  s_lshl_b32 s60, s28, 13
  s_add_u32 s68, s60, 20480
  s_add_u32 s69, s60, 1916928
  s_lshl_b32 s61, s29, 8
  s_lshl_b32 s60, s3, 6
  s_add_u32 s61, s61, s60
  s_add_u32 s70, s61, s69
  s_add_u32 s61, s61, s68
  s_getreg_b32 s31, hwreg(HW_REG_XCC_ID)
  s_and_b32 s31, s31, 15
  s_mov_b32 s62, 0x00010001
  s_mov_b32 s63, 0x00010001
  s_waitcnt lgkmcnt(0)
  s_load_dword s30, s[26:27], 0
  s_barrier
  s_mov_b32 s32, s26
  s_and_b32 s33, s27, 0xffff
  s_mov_b32 s34, 1982464
  s_mov_b32 s35, 0x20000
  s_cmp_ge_u32 s79, 1
  s_cbranch_scc1 L_spin10_done
L_spin10:
  ds_read_b32 v125, v7 offset:0
  s_sub_u32 s82, s82, 1
  s_waitcnt lgkmcnt(0)
  v_readfirstlane_b32 s79, v125
  s_cmp_ge_u32 s79, 1
  s_cbranch_scc1 L_spin10_done
  s_cmp_gt_i32 s82, 0
  s_cbranch_scc1 L_spin10
L_spin10_done:
  ds_read_b64_tr_b16 v[24:25], v120 offset:0
  ds_read_b64_tr_b16 v[26:27], v120 offset:512
  s_cmp_ge_u32 s79, 1
  s_cbranch_scc1 L_spin11_done
L_spin11:
  ds_read_b32 v125, v7 offset:0
  s_sub_u32 s82, s82, 1
  s_waitcnt lgkmcnt(0)
  v_readfirstlane_b32 s79, v125
  s_cmp_ge_u32 s79, 1
  s_cbranch_scc1 L_spin11_done
  s_cmp_gt_i32 s82, 0
  s_cbranch_scc1 L_spin11
L_spin11_done:
  ds_read_b64_tr_b16 v[28:29], v120 offset:4096
  ds_read_b64_tr_b16 v[30:31], v120 offset:4608
  s_cmp_ge_u32 s79, 4
  s_cbranch_scc1 L_spin12_done
L_spin12:
  ds_read_b32 v125, v7 offset:0
  s_sub_u32 s82, s82, 1
  s_waitcnt lgkmcnt(0)
  v_readfirstlane_b32 s79, v125
  s_cmp_ge_u32 s79, 4
  s_cbranch_scc1 L_spin12_done
  s_cmp_gt_i32 s82, 0
  s_cbranch_scc1 L_spin12
L_spin12_done:
  ds_read_b64_tr_b16 v[32:33], v120 offset:8192
  ds_read_b64_tr_b16 v[34:35], v120 offset:8704
  s_cmp_ge_u32 s79, 8
  s_cbranch_scc1 L_spin13_done
L_spin13:
  ds_read_b32 v125, v7 offset:0
  s_sub_u32 s82, s82, 1
  s_waitcnt lgkmcnt(0)
  v_readfirstlane_b32 s79, v125
  s_cmp_ge_u32 s79, 8
  s_cbranch_scc1 L_spin13_done
  s_cmp_gt_i32 s82, 0
  s_cbranch_scc1 L_spin13
L_spin13_done:
  ds_read_b64_tr_b16 v[36:37], v120 offset:12288
  ds_read_b64_tr_b16 v[38:39], v120 offset:12800
  s_add_u32 s30, s30, 16
  s_andn2_b32 s88, s30, 15
  s_or_b32 s88, s88, s31
  v_mov_b32 v23, s88
L_spin14:
  ds_read_b32 v125, v7 offset:256
  s_sub_u32 s82, s82, 1
  s_waitcnt lgkmcnt(0)
  v_readfirstlane_b32 s80, v125
  s_cmp_ge_u32 s80, 1
  s_cbranch_scc1 L_spin14_done
  s_cmp_gt_i32 s82, 0
  s_cbranch_scc1 L_spin14
L_spin14_done:
  ds_read_b128 v[56:59], v5 offset:0
  ds_read_b128 v[60:63], v5 offset:64
  ds_read_b128 v[64:67], v5 offset:128
  ds_read_b128 v[68:71], v5 offset:192
  s_waitcnt lgkmcnt(3)
  v_mfma_f32_16x16x32_bf16 v[72:75], v[24:27], v[56:59], 0
  s_waitcnt lgkmcnt(2)
  v_mfma_f32_16x16x32_bf16 v[72:75], v[28:31], v[60:63], v[72:75]
  s_waitcnt lgkmcnt(1)
  v_mfma_f32_16x16x32_bf16 v[72:75], v[32:35], v[64:67], v[72:75]
  s_waitcnt lgkmcnt(0)
  v_mfma_f32_16x16x32_bf16 v[72:75], v[36:39], v[68:71], v[72:75]
  s_nop 7
  v_perm_b32 v20, v72, v75, s83
  v_perm_b32 v21, v73, v75, s84
  v_perm_b32 v22, v74, v75, s85
  s_mov_b64 exec, s[62:63]
  buffer_store_dwordx4 v[20:23], v121, s[32:35], s70 offen
  buffer_store_dwordx4 v[20:23], v121, s[32:35], s61 offen sc1
  s_mov_b64 exec, -1
  v_lshrrev_b32 v100, 5, v0
  v_and_b32 v101, 31, v0
  v_lshlrev_b32 v18, 4, v101
  v_lshl_add_u32 v18, v100, 12, v18
  s_lshl_b32 s60, s3, 9
  s_add_u32 s68, s68, s60
  s_add_u32 s69, s69, s60
  v_lshlrev_b32 v19, 3, v101
  v_lshl_add_u32 v19, v100, 2, v19
  s_lshl_b32 s60, s3, 8
  s_add_u32 s60, s60, 123904
  v_add_u32 v19, s60, v19
  s_mov_b32 s78, 0
  v_xor_b32 v3, v1, v2
  v_lshlrev_b32 v3, 4, v3
  v_lshl_add_u32 v3, v1, 8, v3
  s_lshl_b32 s60, s3, 13
  s_add_u32 s60, s60, 16384
  v_add_u32 v3, s60, v3
  v_xor_b32 v4, 64, v3
  v_xor_b32 v5, 0x80, v3
  v_xor_b32 v6, 0xc0, v3
  v_and_b32 v100, 3, v1
  v_lshlrev_b32 v8, 8, v100
  v_lshl_add_u32 v8, v2, 4, v8
  v_add_u32 v8, 123904, v8
  v_lshlrev_b32 v10, 4, v100
  v_add_u32 v10, 125952, v10
  s_lshl_b32 s60, s3, 2
  v_add_u32 v9, s60, v10
  v_lshlrev_b32 v12, 6, v2
  v_lshl_add_u32 v12, v100, 4, v12
  v_add_u32 v12, 124928, v12
  s_lshl_b32 s60, s3, 8
  v_and_b32 v11, 12, v1
  v_add3_u32 v11, s60, v12, v11
  s_mov_b32 s48, 0xf0f0f0f0
  s_mov_b32 s49, 0xf0f0f0f0
  s_mov_b32 s50, 0xff00ff00
  s_mov_b32 s51, 0xff00ff00
  v_lshrrev_b32 v101, 2, v1
  v_lshl_add_u32 v101, v2, 2, v101
  v_and_b32 v102, 7, v101
  v_lshlrev_b32 v102, 1, v102
  v_bfe_u32 v103, v1, 1, 1
  s_lshl_b32 s60, s3, 2
  v_add_u32 v103, s60, v103
  v_xor_b32 v102, v102, v103
  v_lshlrev_b32 v102, 4, v102
  v_and_b32 v103, 1, v1
  v_lshl_add_u32 v102, v103, 3, v102
  v_lshl_add_u32 v13, v101, 8, v102
  v_add_u32 v13, 49152, v13
  v_xor_b32 v14, 32, v13
  v_bfe_u32 v101, v1, 2, 1
  v_lshl_add_u32 v101, v101, 2, v2
  v_lshlrev_b32 v15, 4, v101
  v_lshl_add_u32 v15, v100, 9, v15
  s_lshl_b32 s60, s28, 16
  s_lshl_b32 s61, s29, 11
  s_add_u32 s60, s60, s61
  s_lshl_b32 s61, s3, 7
  s_add_u32 s60, s60, s61
  s_add_u32 s72, s60, 327680
  s_add_u32 s73, s60, 851968
  s_lshl_b32 s60, s28, 11
  s_lshl_b32 s61, s29, 4
  s_add_u32 s60, s60, s61
  s_add_u32 s74, s60, 4096
  s_add_u32 s76, s60, 1900544
  v_lshlrev_b32 v17, 9, v0
  v_mov_b32 v16, 1
  s_mov_b32 s62, 0x000f000f
  s_mov_b32 s63, 0x000f000f
  s_mov_b32 s64, 0x00f000f0
  s_mov_b32 s65, 0x00f000f0
  s_mov_b32 s66, 0x00ff00ff
  s_mov_b32 s67, 0x00ff00ff
  s_lshl_b32 s75, s3, 3
  s_add_u32 s75, s75, 32
  s_cmp_ge_u32 s79, 28
  s_cbranch_scc1 L_spin15_done
L_spin15:
  ds_read_b32 v125, v7 offset:0
  s_sub_u32 s82, s82, 1
  s_waitcnt lgkmcnt(0)
  v_readfirstlane_b32 s79, v125
  s_cmp_ge_u32 s79, 28
  s_cbranch_scc1 L_spin15_done
  s_cmp_gt_i32 s82, 0
  s_cbranch_scc1 L_spin15
L_spin15_done:
  buffer_load_dwordx4 v[128:131], v18, s[32:35], s69 offen offset:0 sc1
  buffer_load_dwordx4 v[132:135], v18, s[32:35], s69 offen offset:2048 sc1
  s_cmp_ge_u32 s79, 36
  s_cbranch_scc1 L_spin16_done
L_spin16:
  ds_read_b32 v125, v7 offset:0
  s_sub_u32 s82, s82, 1
  s_waitcnt lgkmcnt(0)
  v_readfirstlane_b32 s79, v125
  s_cmp_ge_u32 s79, 36
  s_cbranch_scc1 L_spin16_done
  s_cmp_gt_i32 s82, 0
  s_cbranch_scc1 L_spin16
L_spin16_done:
  buffer_load_dwordx4 v[136:139], v18, s[32:35], s69 offen offset:0 sc1
  buffer_load_dwordx4 v[140:143], v18, s[32:35], s69 offen offset:2048 sc1
L_q_loop:
  s_add_u32 s78, s78, 1
  s_and_b32 s60, s78, 3
  s_cmp_eq_u32 s60, 3
  s_cselect_b32 s60, s68, s69
  s_sub_u32 s82, s82, 1
  s_waitcnt vmcnt(2)
  v_xor_b32 v100, s88, v131
  v_xor_b32 v101, s88, v135
  v_perm_b32 v107, v129, v128, s86
  v_perm_b32 v108, v133, v132, s86
  v_cmp_lt_u32 s[44:45], 15, v100
  v_cmp_lt_u32 s[46:47], 15, v101
  v_perm_b32 v107, v130, v107, s87
  v_perm_b32 v108, v134, v108, s87
  v_add_f32 v104, v128, v132
  v_add_f32 v105, v129, v133
  v_add_f32 v106, v130, v134
  s_or_b64 vcc, s[44:45], s[46:47]
  s_cbranch_scc0 L_q_done
  s_wqm_b64 exec, s[44:45]
  buffer_load_dwordx4 v[128:131], v18, s[32:35], s60 offen sc1
  s_wqm_b64 exec, s[46:47]
  buffer_load_dwordx4 v[132:135], v18, s[32:35], s60 offen offset:2048 sc1
  s_mov_b64 exec, -1
  s_add_u32 s78, s78, 1
  s_and_b32 s60, s78, 3
  s_cmp_eq_u32 s60, 3
  s_cselect_b32 s60, s68, s69
  s_sub_u32 s82, s82, 1
  s_waitcnt vmcnt(2)
  v_xor_b32 v100, s88, v139
  v_xor_b32 v101, s88, v143
  v_perm_b32 v107, v137, v136, s86
  v_perm_b32 v108, v141, v140, s86
  v_cmp_lt_u32 s[44:45], 15, v100
  v_cmp_lt_u32 s[46:47], 15, v101
  v_perm_b32 v107, v138, v107, s87
  v_perm_b32 v108, v142, v108, s87
  v_add_f32 v104, v136, v140
  v_add_f32 v105, v137, v141
  v_add_f32 v106, v138, v142
  s_or_b64 vcc, s[44:45], s[46:47]
  s_cbranch_scc0 L_q_done
  s_wqm_b64 exec, s[44:45]
  buffer_load_dwordx4 v[136:139], v18, s[32:35], s60 offen sc1
  s_wqm_b64 exec, s[46:47]
  buffer_load_dwordx4 v[140:143], v18, s[32:35], s60 offen offset:2048 sc1
  s_mov_b64 exec, -1
  s_cmp_gt_i32 s82, 0
  s_cbranch_scc1 L_q_loop
L_q_done:
  v_add_f32 v107, v107, v108
  v_or_b32 v100, v100, v101
  v_permlane32_swap_b32 v104, v106
  v_cmp_ne_u32 vcc, 0, v100
  v_permlane32_swap_b32 v105, v107
  v_add_f32 v104, v104, v106
  v_add_f32 v105, v105, v107
  s_cmp_eq_u64 vcc, 0
  s_cselect_b32 s60, 0, 1
  s_or_b32 s60, s60, 0x100
  v_cvt_pk_bf16_f32 v104, v104, v105
  v_mov_b32 v105, s60
  ds_write_b32 v19, v104
  s_mov_b64 exec, 1
  ds_add_u32 v7, v105 offset:260
  s_mov_b64 exec, -1
  s_cmp_ge_u32 s79, s75
  s_cbranch_scc1 L_spin17_done
L_spin17:
  ds_read_b32 v125, v7 offset:0
  s_sub_u32 s82, s82, 1
  s_waitcnt lgkmcnt(0)
  v_readfirstlane_b32 s79, v125
  s_cmp_ge_u32 s79, s75
  s_cbranch_scc1 L_spin17_done
  s_cmp_gt_i32 s82, 0
  s_cbranch_scc1 L_spin17
L_spin17_done:
  ds_read_b128 v[24:27], v3 offset:0
  ds_read_b128 v[28:31], v4 offset:0
  ds_read_b128 v[32:35], v5 offset:0
  ds_read_b128 v[36:39], v6 offset:0
  ds_read_b128 v[40:43], v3 offset:4096
  ds_read_b128 v[44:47], v4 offset:4096
  ds_read_b128 v[48:51], v5 offset:4096
  ds_read_b128 v[52:55], v6 offset:4096
L_spin18:
  ds_read_b32 v125, v7 offset:260
  s_sub_u32 s82, s82, 1
  s_waitcnt lgkmcnt(0)
  v_readfirstlane_b32 s80, v125
  s_cmp_ge_u32 s80, 1024
  s_cbranch_scc1 L_spin18_done
  s_cmp_gt_i32 s82, 0
  s_cbranch_scc1 L_spin18
L_spin18_done:
  s_mov_b32 s52, s80
  ds_read_b128 v[56:59], v8 offset:0
  ds_read_b128 v[60:63], v8 offset:64
  ds_read_b128 v[64:67], v8 offset:128
  ds_read_b128 v[68:71], v8 offset:192
  s_waitcnt lgkmcnt(0)
  v_mfma_f32_16x16x32_bf16 v[72:75], v[24:27], v[56:59], 0
  v_mfma_f32_16x16x32_bf16 v[76:79], v[40:43], v[56:59], 0
  v_mfma_f32_16x16x32_bf16 v[72:75], v[28:31], v[60:63], v[72:75]
  v_mfma_f32_16x16x32_bf16 v[76:79], v[44:47], v[60:63], v[76:79]
  v_mfma_f32_16x16x32_bf16 v[72:75], v[32:35], v[64:67], v[72:75]
  v_mfma_f32_16x16x32_bf16 v[76:79], v[48:51], v[64:67], v[76:79]
  v_mfma_f32_16x16x32_bf16 v[72:75], v[36:39], v[68:71], v[72:75]
  v_mfma_f32_16x16x32_bf16 v[76:79], v[52:55], v[68:71], v[76:79]
  s_nop 6
  v_cndmask_b32 v80, v72, v74, s[48:49]
  v_cndmask_b32 v81, v73, v75, s[48:49]
  v_cndmask_b32 v82, v76, v78, s[48:49]
  v_cndmask_b32 v83, v77, v79, s[48:49]
  v_cndmask_b32 v80, v80, v82, s[50:51]
  v_cndmask_b32 v81, v81, v83, s[50:51]
  v_cvt_pk_bf16_f32 v82, v80, v81
  v_lshlrev_b32 v80, 16, v82
  v_and_b32 v81, 0xffff0000, v82
  v_mul_f32 v80, 0x3db504f3, v80
  v_mul_f32 v81, 0x3db504f3, v81
  v_cvt_pk_bf16_f32 v82, v80, v81
  v_lshlrev_b32 v80, 16, v82
  v_and_b32 v81, 0xffff0000, v82
  v_max_f32 v92, v80, v81
  s_nop 1
  v_max_f32_dpp v92, v92, v92 row_ror:8 row_mask:0xf bank_mask:0xf
  s_nop 1
  v_max_f32_dpp v92, v92, v92 row_ror:4 row_mask:0xf bank_mask:0xf
  v_mov_b32 v93, v92
  s_nop 1
  v_permlane16_swap_b32 v93, v92
  v_max_f32 v92, v92, v93
  v_mov_b32 v93, v92
  s_nop 1
  v_permlane32_swap_b32 v93, v92
  v_max_f32 v92, v92, v93
  v_sub_f32 v80, v80, v92
  v_sub_f32 v81, v81, v92
  v_mul_f32 v80, 0x3fb8aa3b, v80
  v_mul_f32 v81, 0x3fb8aa3b, v81
  v_exp_f32 v80, v80
  v_exp_f32 v81, v81
  s_nop 0
  v_cvt_pk_bf16_f32 v82, v80, v81
  v_add_f32 v93, v80, v81
  ds_write_b32 v11, v82
  s_nop 0
  v_add_f32_dpp v93, v93, v93 row_ror:8 row_mask:0xf bank_mask:0xf
  s_nop 1
  v_add_f32_dpp v93, v93, v93 row_ror:4 row_mask:0xf bank_mask:0xf
  v_mov_b32 v94, v93
  s_nop 1
  v_permlane16_swap_b32 v94, v93
  v_add_f32 v93, v93, v94
  v_mov_b32 v94, v93
  s_nop 1
  v_permlane32_swap_b32 v94, v93
  v_add_f32 v93, v93, v94
  s_mov_b64 exec, 0xf
  ds_write2_b32 v9, v92, v93 offset0:0 offset1:16
  s_mov_b64 exec, 1
  ds_add_u32 v7, v16 offset:268
  s_mov_b64 exec, -1
  v_mov_b32 v118, s30
  v_mov_b32 v119, s30
  v_mov_b32 v23, s30
L_spin19:
  ds_read_b32 v125, v7 offset:268
  s_sub_u32 s82, s82, 1
  s_waitcnt lgkmcnt(0)
  v_readfirstlane_b32 s80, v125
  s_cmp_ge_u32 s80, 4
  s_cbranch_scc1 L_spin19_done
  s_cmp_gt_i32 s82, 0
  s_cbranch_scc1 L_spin19
L_spin19_done:
  ds_read_b128 v[104:107], v10
  ds_read_b128 v[108:111], v10 offset:64
  ds_read_b128 v[24:27], v12 offset:0
  ds_read_b128 v[28:31], v12 offset:256
  ds_read_b128 v[32:35], v12 offset:512
  ds_read_b128 v[36:39], v12 offset:768
  s_waitcnt lgkmcnt(4)
  v_max3_f32 v116, v104, v105, v106
  v_max_f32 v116, v116, v107
  v_sub_f32 v112, v104, v116
  v_sub_f32 v113, v105, v116
  v_sub_f32 v114, v106, v116
  v_sub_f32 v115, v107, v116
  v_mul_f32 v112, 0x3fb8aa3b, v112
  v_mul_f32 v113, 0x3fb8aa3b, v113
  v_mul_f32 v114, 0x3fb8aa3b, v114
  v_mul_f32 v115, 0x3fb8aa3b, v115
  v_exp_f32 v112, v112
  v_exp_f32 v113, v113
  v_exp_f32 v114, v114
  v_exp_f32 v115, v115
  s_cmp_lg_u32 s3, 0
  s_cbranch_scc1 L_a_noml
  v_mul_f32 v117, v112, v108
  v_mul_f32 v110, v114, v110
  v_fmac_f32 v117, v113, v109
  v_fmac_f32 v110, v115, v111
  s_mov_b64 exec, 0xf
  v_add_f32 v117, v117, v110
  buffer_store_dwordx4 v[116:119], v17, s[32:35], s76 offen
  s_cmp_eq_u32 s52, 0x400
  s_cbranch_scc1 L_a_ml2
  buffer_store_dwordx4 v[116:119], v17, s[32:35], s74 offen sc1
L_a_ml2:
  s_mov_b64 exec, -1
L_a_noml:
  s_cmp_ge_u32 s79, 72
  s_cbranch_scc1 L_spin20_done
L_spin20:
  ds_read_b32 v125, v7 offset:0
  s_sub_u32 s82, s82, 1
  s_waitcnt lgkmcnt(0)
  v_readfirstlane_b32 s79, v125
  s_cmp_ge_u32 s79, 72
  s_cbranch_scc1 L_spin20_done
  s_cmp_gt_i32 s82, 0
  s_cbranch_scc1 L_spin20
L_spin20_done:
  ds_read_b64_tr_b16 v[40:41], v13 offset:0
  ds_read_b64_tr_b16 v[42:43], v13 offset:4096
  ds_read_b64_tr_b16 v[44:45], v14 offset:0
  ds_read_b64_tr_b16 v[46:47], v14 offset:4096
  ds_read_b64_tr_b16 v[48:49], v13 offset:8192
  ds_read_b64_tr_b16 v[50:51], v13 offset:12288
  ds_read_b64_tr_b16 v[52:53], v14 offset:8192
  ds_read_b64_tr_b16 v[54:55], v14 offset:12288
  s_cmp_ge_u32 s79, 80
  s_cbranch_scc1 L_spin21_done
L_spin21:
  ds_read_b32 v125, v7 offset:0
  s_sub_u32 s82, s82, 1
  s_waitcnt lgkmcnt(0)
  v_readfirstlane_b32 s79, v125
  s_cmp_ge_u32 s79, 80
  s_cbranch_scc1 L_spin21_done
  s_cmp_gt_i32 s82, 0
  s_cbranch_scc1 L_spin21
L_spin21_done:
  s_waitcnt lgkmcnt(8)
  ds_read_b64_tr_b16 v[56:57], v13 offset:16384
  ds_read_b64_tr_b16 v[58:59], v13 offset:20480
  ds_read_b64_tr_b16 v[60:61], v14 offset:16384
  ds_read_b64_tr_b16 v[62:63], v14 offset:20480
  s_waitcnt lgkmcnt(8)
  v_mfma_f32_16x16x32_bf16 v[72:75], v[40:43], v[24:27], 0
  v_mfma_f32_16x16x32_bf16 v[76:79], v[44:47], v[24:27], 0
  s_waitcnt lgkmcnt(4)
  v_mfma_f32_16x16x32_bf16 v[80:83], v[48:51], v[28:31], 0
  v_mfma_f32_16x16x32_bf16 v[84:87], v[52:55], v[28:31], 0
  s_cmp_ge_u32 s79, 88
  s_cbranch_scc1 L_spin22_done
L_spin22:
  ds_read_b32 v125, v7 offset:0
  s_sub_u32 s82, s82, 1
  s_waitcnt lgkmcnt(0)
  v_readfirstlane_b32 s79, v125
  s_cmp_ge_u32 s79, 88
  s_cbranch_scc1 L_spin22_done
  s_cmp_gt_i32 s82, 0
  s_cbranch_scc1 L_spin22
L_spin22_done:
  ds_read_b64_tr_b16 v[64:65], v13 offset:24576
  ds_read_b64_tr_b16 v[66:67], v13 offset:28672
  ds_read_b64_tr_b16 v[68:69], v14 offset:24576
  ds_read_b64_tr_b16 v[70:71], v14 offset:28672
  s_waitcnt lgkmcnt(4)
  v_mfma_f32_16x16x32_bf16 v[88:91], v[56:59], v[32:35], 0
  v_mfma_f32_16x16x32_bf16 v[92:95], v[60:63], v[32:35], 0
  v_cndmask_b32 v72, v72, v76, s[64:65]
  v_cndmask_b32 v73, v73, v77, s[64:65]
  v_cndmask_b32 v74, v74, v78, s[64:65]
  v_cndmask_b32 v75, v75, v79, s[64:65]
  v_mul_f32 v104, v112, v72
  v_mul_f32 v105, v112, v73
  v_mul_f32 v106, v112, v74
  v_mul_f32 v107, v112, v75
  v_cndmask_b32 v80, v80, v84, s[64:65]
  v_cndmask_b32 v81, v81, v85, s[64:65]
  v_cndmask_b32 v82, v82, v86, s[64:65]
  v_cndmask_b32 v83, v83, v87, s[64:65]
  v_fmac_f32 v104, v113, v80
  v_fmac_f32 v105, v113, v81
  v_fmac_f32 v106, v113, v82
  v_fmac_f32 v107, v113, v83
  v_cndmask_b32 v88, v88, v92, s[64:65]
  v_cndmask_b32 v89, v89, v93, s[64:65]
  v_cndmask_b32 v90, v90, v94, s[64:65]
  v_cndmask_b32 v91, v91, v95, s[64:65]
  v_fmac_f32 v104, v114, v88
  v_fmac_f32 v105, v114, v89
  v_fmac_f32 v106, v114, v90
  v_fmac_f32 v107, v114, v91
  s_waitcnt lgkmcnt(0)
  v_mfma_f32_16x16x32_bf16 v[96:99], v[64:67], v[36:39], 0
  v_mfma_f32_16x16x32_bf16 v[100:103], v[68:71], v[36:39], 0
  s_nop 7
  v_cndmask_b32 v96, v96, v100, s[64:65]
  v_cndmask_b32 v97, v97, v101, s[64:65]
  v_cndmask_b32 v98, v98, v102, s[64:65]
  v_cndmask_b32 v99, v99, v103, s[64:65]
  v_fmac_f32 v104, v115, v96
  v_fmac_f32 v105, v115, v97
  v_fmac_f32 v106, v115, v98
  v_fmac_f32 v107, v115, v99
  v_perm_b32 v20, v104, v107, s83
  v_perm_b32 v21, v105, v107, s84
  v_perm_b32 v22, v106, v107, s85
  s_mov_b64 exec, s[66:67]
  buffer_store_dwordx4 v[20:23], v15, s[32:35], s73 offen
  s_cmp_eq_u32 s52, 0x400
  s_cbranch_scc1 L_a_o2
  buffer_store_dwordx4 v[20:23], v15, s[32:35], s72 offen sc1
L_a_o2:
  s_mov_b64 exec, -1
  s_and_b32 s60, s29, 3
  s_cmp_eq_u32 s60, 0
  s_cbranch_scc1 L_final
  s_endpgm
L_code_end:
.section .rodata,"a"
.p2align 6
.amdhsa_kernel recurrent_scan__sliding_block_cached__glu_gated_geglu__decode_kernel
  .amdhsa_next_free_vgpr 160
  .amdhsa_next_free_sgpr 100
  .amdhsa_accum_offset 160
  .amdhsa_group_segment_fixed_size 0
  .amdhsa_kernarg_size 96
  .amdhsa_user_sgpr_count 2
  .amdhsa_user_sgpr_kernarg_segment_ptr 1
  .amdhsa_system_sgpr_workgroup_id_x 1
.end_amdhsa_kernel
```
